```python
import torch

def _softmax(x, axis=-1):
    return torch.softmax(x, dim=axis)
def _gelu(x):
    return torch.nn.functional.gelu(x, approximate="tanh")
def _silu(x):
    return torch.nn.functional.silu(x)
def _sigmoid(x):
    return torch.sigmoid(x)
def _layernorm(x, axis=-1, eps=1e-5):
    m = x.mean(dim=axis, keepdim=True)
    v = x.var(dim=axis, keepdim=True, unbiased=False)
    return (x - m) / torch.sqrt(v + eps)
def _scatter_add(tgt, idx, src, axis=0):
    return tgt.clone().index_add_(axis, idx, src)
def _segment_sum(src, seg, n):
    out = torch.zeros((n,) + src.shape[1:], dtype=src.dtype)
    return out.index_add_(0, seg, src)
def _pad(x, pw):
    flat = tuple(v for pair in reversed(pw) for v in pair)
    return torch.nn.functional.pad(x, flat)

kernel_name = 'standalone__channel_attn_cbam__vision'

def setup_inputs():

    _w = (lambda a: (lambda t: t.to(torch.bfloat16) if t.is_floating_point() else t)(torch.as_tensor(a)))
    H = W = 256
    C = 384
    r = max(C // 4, 1)
    return {
        "x": _w((lambda *s: torch.randn(*s, dtype=torch.bfloat16) * 0.1)(1, H, W, C) + (lambda *s: torch.randn(*s, dtype=torch.bfloat16) * 0.1)(1, 1, 1, C) * 2.0),
        "w1": _w((lambda *s: torch.randn(*s, dtype=torch.bfloat16) * 0.1)(C, r)),
        "w2": _w((lambda *s: torch.randn(*s, dtype=torch.bfloat16) * 0.1)(r, C)),
    }

def reference(x, w1, w2):
    B, H, W, C = x.shape
    xf = x.reshape(B, H * W, C)
    gap = torch.mean(xf, 1)
    gmp = torch.amax(xf, 1)
    h_a = gap @ w1
    h_a = h_a * (lambda x, dt: x.to(dt))(h_a > 0, h_a.dtype)
    h_m = gmp @ w1
    h_m = h_m * (lambda x, dt: x.to(dt))(h_m > 0, h_m.dtype)
    scale = _sigmoid(h_a @ w2 + h_m @ w2)
    return x * scale[:, None, None, :]
```

```asm
; @launch grid=(256,1,1) block=(512,1,1) lds=118784
.amdgcn_target "amdgcn-amd-amdhsa--gfx950"
.text
.globl standalone__channel_attn_cbam__vision_kernel
.p2align 8
.type standalone__channel_attn_cbam__vision_kernel,@function
standalone__channel_attn_cbam__vision_kernel:
    s_load_dwordx2 s[16:17], s[0:1], 0
    v_mul_u32_u24 v2, 12, v0
    s_mul_i32 s40, s2, 196608
    s_mov_b32 s18, 50331648
    s_mov_b32 s19, 0x20000
    s_lshr_b32 s5, s2, 3
    s_or_b32 s4, s5, 1
    s_cmp_eq_u32 s4, 7
    s_cbranch_scc1 L_probe
L_probeback:
    s_waitcnt lgkmcnt(0)
L_probeback2:
    buffer_load_dwordx3 v[104:106], v2, s[16:19], s40 offen nt
    s_addk_i32 s40, 6144
    buffer_load_dwordx3 v[108:110], v2, s[16:19], s40 offen nt
    s_addk_i32 s40, 6144
    buffer_load_dwordx3 v[112:114], v2, s[16:19], s40 offen nt
    s_addk_i32 s40, 6144
    buffer_load_dwordx3 v[116:118], v2, s[16:19], s40 offen nt
    s_addk_i32 s40, 6144
    buffer_load_dwordx3 v[120:122], v2, s[16:19], s40 offen nt
    s_addk_i32 s40, 6144
    buffer_load_dwordx3 v[124:126], v2, s[16:19], s40 offen nt
    s_addk_i32 s40, 6144
    buffer_load_dwordx3 v[128:130], v2, s[16:19], s40 offen nt
    s_addk_i32 s40, 6144
    buffer_load_dwordx3 v[132:134], v2, s[16:19], s40 offen nt
    s_branch L_noprobe
L_probe:
    v_readfirstlane_b32 s3, v0
    s_cmp_eq_u32 s5, 7
    s_cselect_b32 s44, 24, 40
    s_load_dwordx2 s[28:29], s[0:1], s44
    s_load_dwordx2 s[32:33], s[0:1], 32
    s_memrealtime s[10:11]
    s_and_b32 s4, s2, 7
    s_mov_b32 s46, 0
    s_cmp_eq_u32 s3, 0
    s_cbranch_scc1 L_time
    s_barrier
    s_branch L_probeback
L_issue:
    s_mov_b32 s46, 1
    s_lshl_b32 s42, s4, 23
    s_cmp_eq_u32 s5, 7
    s_cselect_b32 s42, s42, 1048576
    s_lshl_b32 s43, s4, 14
    s_add_u32 s42, s42, s43
    v_mov_b32 v5, 0
    s_mov_b64 exec, 1
    s_mov_b32 s30, 50331648
    s_mov_b32 s31, 0x20000
    s_waitcnt lgkmcnt(0)
    s_sub_u32 s43, 0x800, s28
    s_and_b32 s43, s43, 0x3ffc
    s_sub_u32 s45, s16, s28
    s_addk_i32 s45, 2048
    s_bitcmp1_b32 s45, 12
    s_cselect_b32 s45, 2.0, 0
    s_cmp_eq_u32 s5, 7
    s_cselect_b32 s43, s43, 6400
    s_cselect_b32 s45, s45, 2.0
    s_add_u32 s42, s42, s43
    s_add_u32 s43, s42, 8192
    v_mov_b32 v8, s45
    s_branch L_timed
    .p2alignl 6, 0xbf800000
L_timed:
    buffer_store_dword v5, v5, s[28:31], s42 offen sc1
    buffer_store_dword v5, v5, s[28:31], s43 offen sc1
    buffer_load_dword v6, v8, s[16:19], s42 offen nt
    buffer_load_dword v7, v8, s[16:19], s43 offen nt
    s_barrier
    s_cmp_lg_u32 s2, 56
    s_cbranch_scc1 L_time
    s_or_b32 s10, s10, 1
    s_bitset1_b32 s11, 31
    s_atomic_swap_x2 s[10:11], s[32:33], 0 glc
L_time:
    s_waitcnt vmcnt(3)
    s_memtime s[52:53]
    s_waitcnt vmcnt(2)
    s_memtime s[54:55]
    s_waitcnt vmcnt(1)
    s_memtime s[56:57]
    s_waitcnt vmcnt(0)
    s_memtime s[58:59]
    s_cmp_eq_u32 s46, 0
    s_cbranch_scc1 L_issue
    s_mov_b64 exec, -1
    s_add_u32 s43, s42, s28
    s_bfe_u32 s43, s43, 0x10015
    s_and_b32 s43, s43, s5
    s_mul_i32 s43, s43, 0x1000100
    s_getreg_b32 s42, hwreg(HW_REG_XCC_ID, 2, 1)
    s_mul_i32 s42, s42, 0x1010100
    s_xor_b32 s42, s42, s43
    s_sub_u32 s44, 9, s5
    s_lshl_b32 s44, s44, 2
    s_waitcnt lgkmcnt(0)
    s_sub_u32 s43, s54, s52
    s_sub_u32 s58, s58, s56
    s_cmp_lt_u32 s43, 40
    s_cselect_b32 s43, 0x101, 1
    s_xor_b32 s56, s43, s42
    s_cmp_lt_u32 s58, 30
    s_cselect_b32 s43, 0x1000000, 0
    s_xor_b32 s56, s56, s43
    s_lshl_b32 s56, s56, s4
    s_atomic_or s56, s[32:33], s44 glc
    s_branch L_probeback2
L_noprobe:
    s_cmp_ge_u32 s2, 256
    s_cbranch_scc1 L_end
    v_lshrrev_b32 v3, 6, v0
    v_and_b32 v1, 63, v0
    s_mov_b32 s34, 256
    v_readfirstlane_b32 s3, v3
    s_mov_b32 s35, 0x20000
    v_mov_b32 v107, 0
    s_load_dwordx2 s[28:29], s[0:1], 24
    s_load_dwordx2 s[32:33], s[0:1], 32
    s_load_dwordx2 s[36:37], s[0:1], 40
    s_load_dwordx2 s[20:21], s[0:1], 8
    s_load_dwordx2 s[24:25], s[0:1], 16
    s_mov_b32 s38, 1572864
    s_mov_b32 s39, 0x20000
    s_mov_b32 s22, 73728
    s_mov_b32 s23, 0x20000
    s_mov_b32 s26, 73728
    s_mov_b32 s27, 0x20000
    s_mov_b32 s30, 50331648
    s_mov_b32 s31, 0x20000
    s_mov_b32 s48, 0xffff0000
    s_mov_b32 s12, 0
    s_getreg_b32 s13, hwreg(HW_REG_XCC_ID, 0, 1)
    s_and_b32 s4, s2, 7
    s_lshr_b32 s5, s2, 3
    v_lshlrev_b32 v4, 4, v1
    v_xor_b32 v3, 0x1c0, v0
    v_mul_u32_u24 v111, 12, v3
    v_lshrrev_b32 v44, 4, v1
    v_and_b32 v45, 3, v1
    v_and_b32 v46, 1, v1
    v_bfe_u32 v47, v1, 4, 1
    v_bfe_u32 v48, v1, 2, 2
    v_and_b32 v49, 0x70, v4
    s_mul_i32 s45, s3, 3072
    s_add_u32 s45, s45, 90112
    v_mul_u32_u24 v3, 48, v1
    v_add_u32 v115, s45, v3
    v_add_u32 v119, s45, v4
    v_lshlrev_b32 v3, 4, v0
    v_add_u32 v123, 90112, v3
    s_mul_i32 s49, s4, 98304
    s_lshl_b32 s45, s5, 7
    s_add_u32 s45, s45, s49
    v_lshrrev_b32 v3, 3, v0
    v_lshl_add_u32 v3, v3, 12, v49
    v_add_u32 v127, s45, v3
    s_sub_u32 s51, s5, 8
    s_lshl_b32 s45, s51, 12
    s_add_u32 s45, s45, s49
    v_add_u32 v131, s45, v4
    s_mul_i32 s45, s5, 3072
    s_add_u32 s45, s45, s49
    v_lshlrev_b32 v3, 7, v1
    v_add_u32 v5, s45, v3
    s_xor_b32 s45, s4, 1
    s_lshl_b32 s45, s45, 16
    s_lshr_b32 s43, s5, 3
    s_lshl_b32 s43, s43, 14
    s_add_u32 s45, s45, s43
    s_and_b32 s43, s5, 7
    s_mul_i32 s43, s43, 768
    s_add_u32 s45, s45, s43
    s_add_u32 s45, s45, 1045504
    v_add_u32 v6, s45, v3
    v_cmp_gt_u32 vcc, 24, v1
    s_lshl_b32 s45, s4, 11
    s_lshl_b32 s43, s5, 6
    v_cndmask_b32 v5, v6, v5, vcc
    s_add_u32 s45, s45, s43
    s_add_u32 s45, s45, 786432
    v_mov_b32 v6, s45
    v_cmp_gt_u32 vcc, 30, v1
    s_cmp_eq_u32 s3, 5
    s_cselect_b32 s45, 31, 0
    v_cndmask_b32 v5, v6, v5, vcc
    v_cmp_gt_u32 vcc, s45, v1
    v_mov_b32 v6, 2.0
    s_mul_i32 s45, s5, 2304
    v_cndmask_b32 v135, v6, v5, vcc
    v_add_u32 v5, s45, v3
    s_cmp_eq_u32 s3, 6
    s_cselect_b32 s45, 18, 0
    v_cmp_gt_u32 vcc, s45, v1
    s_nop 1
    v_cndmask_b32 v139, v6, v5, vcc
    s_lshr_b32 s45, s4, 1
    s_lshl_b32 s45, s45, 14
    s_and_b32 s49, s4, 1
    s_mul_i32 s49, s49, 3072
    s_add_u32 s45, s45, s49
    s_lshl_b32 s49, s51, 7
    s_add_u32 s45, s45, s49
    s_add_u32 s45, s45, 1048576
    v_lshrrev_b32 v3, 3, v1
    v_lshlrev_b32 v3, 16, v3
    v_add3_u32 v143, v3, v49, s45
    s_lshl_b32 s45, s4, 16
    s_lshl_b32 s49, s3, 9
    s_add_u32 s45, s45, s49
    s_add_u32 s45, s45, 1048576
    v_lshrrev_b32 v3, 5, v1
    v_mul_u32_u24 v3, 2560, v3
    v_add3_u32 v147, v3, v4, s45
    s_lshl_b32 s45, s4, 11
    s_add_u32 s45, s45, 786432
    v_add_u32 v151, s45, v4
    s_lshl_b32 s49, s5, 2
    s_add_u32 s49, s49, s3
    s_lshl_b32 s49, s49, 6
    s_add_u32 s45, s45, s49
    v_lshl_add_u32 v155, v1, 2, s45
    v_and_b32 v3, 0x19, v1
    s_lshl_b32 s45, s3, 5
    v_add_u32 v3, s45, v3
    v_bfe_u32 v5, v0, 1, 1
    v_lshl_add_u32 v3, v5, 2, v3
    v_bfe_u32 v5, v0, 2, 1
    v_lshl_add_u32 v3, v5, 1, v3
    v_lshlrev_b32 v3, 2, v3
    v_add_u32 v159, 114688, v3
    v_mul_u32_u24 v3, 832, v46
    v_lshl_add_u32 v3, v44, 4, v3
    v_add_u32 v163, 114688, v3
    v_mul_u32_u24 v3, 192, v46
    v_add_u32 v3, 116736, v3
    v_lshl_add_u32 v167, v44, 4, v3
    v_lshl_add_u32 v3, v47, 4, v3
    v_lshrrev_b32 v5, 5, v1
    v_lshl_add_u32 v3, v5, 3, v3
    s_lshl_b32 s45, s3, 5
    v_add_u32 v171, s45, v3
    v_add_u32 v175, 117248, v4
    v_mul_u32_u24 v3, 24, v1
    v_add_u32 v179, 117248, v3
    s_and_b32 s45, s45, 32
    v_xor_b32 v183, s45, v4
    v_lshrrev_b32 v3, 3, v1
    v_mul_u32_u24 v3, 768, v3
    s_lshl_b32 s45, s5, 7
    v_add3_u32 v187, v3, v49, s45
    v_lshl_add_u32 v6, v47, 2, v48
    v_lshl_add_u32 v7, v5, 4, v6
    v_xor_b32 v3, s3, v47
    v_lshlrev_b32 v3, 5, v3
    v_lshl_add_u32 v3, v45, 3, v3
    v_mul_u32_u24 v5, 192, v7
    v_add_u32 v191, v3, v5
    v_add_u32 v195, 36864, v191
    v_lshlrev_b32 v5, 7, v7
    v_lshl_add_u32 v5, v45, 3, v5
    s_and_b32 s45, s3, 3
    s_lshl_b32 s45, s45, 5
    s_add_u32 s45, s45, 73728
    v_add_u32 v199, s45, v5
    s_mov_b32 s49, 0x7fff7fff
    s_add_u32 s51, s2, 1
    s_mul_i32 s51, s51, 196608
    s_waitcnt lgkmcnt(0)
    s_bfe_u32 s41, s28, 0x3000b
    s_mul_i32 s41, s41, 5
    s_and_b32 s41, s41, 7
    s_mulk_i32 s41, 6144
    s_waitcnt vmcnt(7)
    v_lshlrev_b32 v20, 16, v104
    v_and_b32 v21, s48, v104
    v_lshlrev_b32 v22, 16, v105
    v_and_b32 v23, s48, v105
    v_lshlrev_b32 v24, 16, v106
    v_and_b32 v25, s48, v106
    s_addk_i32 s40, 12288
    s_add_u32 s40, s40, s41
    buffer_load_dwordx3 v[136:138], v2, s[16:19], s40 offen nt
    s_waitcnt vmcnt(7)
    v_lshlrev_b32 v26, 16, v108
    v_and_b32 v27, s48, v108
    v_lshlrev_b32 v28, 16, v109
    v_and_b32 v29, s48, v109
    v_lshlrev_b32 v30, 16, v110
    v_and_b32 v31, s48, v110
    s_addk_i32 s40, 6144
    buffer_load_dwordx3 v[140:142], v2, s[16:19], s40 offen nt
    v_pk_add_f32 v[8:9], v[20:21], v[26:27]
    v_pk_add_f32 v[12:13], v[22:23], v[28:29]
    v_pk_add_f32 v[16:17], v[24:25], v[30:31]
    v_max_f32 v10, v20, v26
    v_max_f32 v11, v21, v27
    v_max_f32 v14, v22, v28
    v_max_f32 v15, v23, v29
    v_max_f32 v18, v24, v30
    v_max_f32 v19, v25, v31
    s_waitcnt vmcnt(7)
    v_lshlrev_b32 v20, 16, v112
    v_and_b32 v21, s48, v112
    v_lshlrev_b32 v22, 16, v113
    v_and_b32 v23, s48, v113
    v_lshlrev_b32 v24, 16, v114
    v_and_b32 v25, s48, v114
    s_addk_i32 s40, 18432
    buffer_load_dwordx3 v[144:146], v2, s[16:19], s40 offen nt
    v_pk_add_f32 v[8:9], v[8:9], v[20:21]
    v_pk_add_f32 v[12:13], v[12:13], v[22:23]
    v_pk_add_f32 v[16:17], v[16:17], v[24:25]
    s_waitcnt vmcnt(7)
    v_lshlrev_b32 v26, 16, v116
    v_and_b32 v27, s48, v116
    v_lshlrev_b32 v28, 16, v117
    v_and_b32 v29, s48, v117
    v_lshlrev_b32 v30, 16, v118
    v_and_b32 v31, s48, v118
    s_addk_i32 s40, 6144
    buffer_load_dwordx3 v[148:150], v2, s[16:19], s40 offen nt
    v_pk_add_f32 v[8:9], v[8:9], v[26:27]
    v_pk_add_f32 v[12:13], v[12:13], v[28:29]
    v_pk_add_f32 v[16:17], v[16:17], v[30:31]
    v_max3_f32 v10, v10, v20, v26
    v_max3_f32 v11, v11, v21, v27
    v_max3_f32 v14, v14, v22, v28
    v_max3_f32 v15, v15, v23, v29
    v_max3_f32 v18, v18, v24, v30
    v_max3_f32 v19, v19, v25, v31
    s_waitcnt vmcnt(7)
    v_lshlrev_b32 v20, 16, v120
    v_and_b32 v21, s48, v120
    v_lshlrev_b32 v22, 16, v121
    v_and_b32 v23, s48, v121
    v_lshlrev_b32 v24, 16, v122
    v_and_b32 v25, s48, v122
    s_addk_i32 s40, 18432
    buffer_load_dwordx3 v[152:154], v2, s[16:19], s40 offen nt
    v_pk_add_f32 v[8:9], v[8:9], v[20:21]
    v_pk_add_f32 v[12:13], v[12:13], v[22:23]
    v_pk_add_f32 v[16:17], v[16:17], v[24:25]
    s_waitcnt vmcnt(7)
    v_lshlrev_b32 v26, 16, v124
    v_and_b32 v27, s48, v124
    v_lshlrev_b32 v28, 16, v125
    v_and_b32 v29, s48, v125
    v_lshlrev_b32 v30, 16, v126
    v_and_b32 v31, s48, v126
    s_addk_i32 s40, 6144
    buffer_load_dwordx3 v[156:158], v2, s[16:19], s40 offen nt
    v_pk_add_f32 v[8:9], v[8:9], v[26:27]
    v_pk_add_f32 v[12:13], v[12:13], v[28:29]
    v_pk_add_f32 v[16:17], v[16:17], v[30:31]
    v_max3_f32 v10, v10, v20, v26
    v_max3_f32 v11, v11, v21, v27
    v_max3_f32 v14, v14, v22, v28
    v_max3_f32 v15, v15, v23, v29
    v_max3_f32 v18, v18, v24, v30
    v_max3_f32 v19, v19, v25, v31
    s_waitcnt vmcnt(7)
    v_lshlrev_b32 v20, 16, v128
    v_and_b32 v21, s48, v128
    v_lshlrev_b32 v22, 16, v129
    v_and_b32 v23, s48, v129
    v_lshlrev_b32 v24, 16, v130
    v_and_b32 v25, s48, v130
    s_addk_i32 s40, 18432
    buffer_load_dwordx3 v[160:162], v2, s[16:19], s40 offen nt
    v_pk_add_f32 v[8:9], v[8:9], v[20:21]
    v_pk_add_f32 v[12:13], v[12:13], v[22:23]
    v_pk_add_f32 v[16:17], v[16:17], v[24:25]
    s_waitcnt vmcnt(7)
    v_lshlrev_b32 v26, 16, v132
    v_and_b32 v27, s48, v132
    v_lshlrev_b32 v28, 16, v133
    v_and_b32 v29, s48, v133
    v_lshlrev_b32 v30, 16, v134
    v_and_b32 v31, s48, v134
    s_addk_i32 s40, 6144
    buffer_load_dwordx3 v[164:166], v2, s[16:19], s40 offen nt
    v_pk_add_f32 v[8:9], v[8:9], v[26:27]
    v_pk_add_f32 v[12:13], v[12:13], v[28:29]
    v_pk_add_f32 v[16:17], v[16:17], v[30:31]
    v_max3_f32 v10, v10, v20, v26
    v_max3_f32 v11, v11, v21, v27
    v_max3_f32 v14, v14, v22, v28
    v_max3_f32 v15, v15, v23, v29
    v_max3_f32 v18, v18, v24, v30
    v_max3_f32 v19, v19, v25, v31
    buffer_load_dwordx4 v[34:37], v107, s[32:35], 0 offen sc1
    s_waitcnt vmcnt(8)
    v_lshlrev_b32 v20, 16, v136
    v_and_b32 v21, s48, v136
    v_lshlrev_b32 v22, 16, v137
    v_and_b32 v23, s48, v137
    v_lshlrev_b32 v24, 16, v138
    v_and_b32 v25, s48, v138
    s_addk_i32 s40, 12288
    buffer_load_dwordx3 v[168:170], v2, s[16:19], s40 offen nt
    v_pk_add_f32 v[8:9], v[8:9], v[20:21]
    v_pk_add_f32 v[12:13], v[12:13], v[22:23]
    v_pk_add_f32 v[16:17], v[16:17], v[24:25]
    s_waitcnt vmcnt(8)
    v_lshlrev_b32 v26, 16, v140
    v_and_b32 v27, s48, v140
    v_lshlrev_b32 v28, 16, v141
    v_and_b32 v29, s48, v141
    v_lshlrev_b32 v30, 16, v142
    v_and_b32 v31, s48, v142
    s_addk_i32 s40, 6144
    s_cmp_ge_u32 s40, s51
    s_cselect_b32 s47, 147456, 0
    s_sub_u32 s40, s40, s47
    buffer_load_dwordx3 v[172:174], v2, s[16:19], s40 offen nt
    v_pk_add_f32 v[8:9], v[8:9], v[26:27]
    v_pk_add_f32 v[12:13], v[12:13], v[28:29]
    v_pk_add_f32 v[16:17], v[16:17], v[30:31]
    v_max3_f32 v10, v10, v20, v26
    v_max3_f32 v11, v11, v21, v27
    v_max3_f32 v14, v14, v22, v28
    v_max3_f32 v15, v15, v23, v29
    v_max3_f32 v18, v18, v24, v30
    v_max3_f32 v19, v19, v25, v31
    s_waitcnt vmcnt(8)
    v_lshlrev_b32 v20, 16, v144
    v_and_b32 v21, s48, v144
    v_lshlrev_b32 v22, 16, v145
    v_and_b32 v23, s48, v145
    v_lshlrev_b32 v24, 16, v146
    v_and_b32 v25, s48, v146
    s_addk_i32 s40, 6144
    s_cmp_ge_u32 s40, s51
    s_cselect_b32 s47, 147456, 0
    s_sub_u32 s40, s40, s47
    buffer_load_dwordx3 v[176:178], v2, s[16:19], s40 offen nt
    v_pk_add_f32 v[8:9], v[8:9], v[20:21]
    v_pk_add_f32 v[12:13], v[12:13], v[22:23]
    v_pk_add_f32 v[16:17], v[16:17], v[24:25]
    s_waitcnt vmcnt(8)
    v_lshlrev_b32 v26, 16, v148
    v_and_b32 v27, s48, v148
    v_lshlrev_b32 v28, 16, v149
    v_and_b32 v29, s48, v149
    v_lshlrev_b32 v30, 16, v150
    v_and_b32 v31, s48, v150
    s_addk_i32 s40, 6144
    s_cmp_ge_u32 s40, s51
    s_cselect_b32 s47, 147456, 0
    s_sub_u32 s40, s40, s47
    buffer_load_dwordx3 v[180:182], v2, s[16:19], s40 offen nt
    v_pk_add_f32 v[8:9], v[8:9], v[26:27]
    v_pk_add_f32 v[12:13], v[12:13], v[28:29]
    v_pk_add_f32 v[16:17], v[16:17], v[30:31]
    v_max3_f32 v10, v10, v20, v26
    v_max3_f32 v11, v11, v21, v27
    v_max3_f32 v14, v14, v22, v28
    v_max3_f32 v15, v15, v23, v29
    v_max3_f32 v18, v18, v24, v30
    v_max3_f32 v19, v19, v25, v31
    s_waitcnt vmcnt(8)
    v_lshlrev_b32 v20, 16, v152
    v_and_b32 v21, s48, v152
    v_lshlrev_b32 v22, 16, v153
    v_and_b32 v23, s48, v153
    v_lshlrev_b32 v24, 16, v154
    v_and_b32 v25, s48, v154
    s_addk_i32 s40, 6144
    s_cmp_ge_u32 s40, s51
    s_cselect_b32 s47, 147456, 0
    s_sub_u32 s40, s40, s47
    buffer_load_dwordx3 v[184:186], v2, s[16:19], s40 offen nt
    v_pk_add_f32 v[8:9], v[8:9], v[20:21]
    v_pk_add_f32 v[12:13], v[12:13], v[22:23]
    v_pk_add_f32 v[16:17], v[16:17], v[24:25]
    s_waitcnt vmcnt(8)
    v_lshlrev_b32 v26, 16, v156
    v_and_b32 v27, s48, v156
    v_lshlrev_b32 v28, 16, v157
    v_and_b32 v29, s48, v157
    v_lshlrev_b32 v30, 16, v158
    v_and_b32 v31, s48, v158
    s_addk_i32 s40, 6144
    s_cmp_ge_u32 s40, s51
    s_cselect_b32 s47, 147456, 0
    s_sub_u32 s40, s40, s47
    buffer_load_dwordx3 v[188:190], v2, s[16:19], s40 offen nt
    v_pk_add_f32 v[8:9], v[8:9], v[26:27]
    v_pk_add_f32 v[12:13], v[12:13], v[28:29]
    v_pk_add_f32 v[16:17], v[16:17], v[30:31]
    v_max3_f32 v10, v10, v20, v26
    v_max3_f32 v11, v11, v21, v27
    v_max3_f32 v14, v14, v22, v28
    v_max3_f32 v15, v15, v23, v29
    v_max3_f32 v18, v18, v24, v30
    v_max3_f32 v19, v19, v25, v31
    s_waitcnt vmcnt(8)
    v_lshlrev_b32 v20, 16, v160
    v_and_b32 v21, s48, v160
    v_lshlrev_b32 v22, 16, v161
    v_and_b32 v23, s48, v161
    v_lshlrev_b32 v24, 16, v162
    v_and_b32 v25, s48, v162
    s_addk_i32 s40, 6144
    s_cmp_ge_u32 s40, s51
    s_cselect_b32 s47, 147456, 0
    s_sub_u32 s40, s40, s47
    buffer_load_dwordx3 v[192:194], v2, s[16:19], s40 offen nt
    v_pk_add_f32 v[8:9], v[8:9], v[20:21]
    v_pk_add_f32 v[12:13], v[12:13], v[22:23]
    v_pk_add_f32 v[16:17], v[16:17], v[24:25]
    s_waitcnt vmcnt(8)
    v_lshlrev_b32 v26, 16, v164
    v_and_b32 v27, s48, v164
    v_lshlrev_b32 v28, 16, v165
    v_and_b32 v29, s48, v165
    v_lshlrev_b32 v30, 16, v166
    v_and_b32 v31, s48, v166
    s_addk_i32 s40, 6144
    s_cmp_ge_u32 s40, s51
    s_cselect_b32 s47, 147456, 0
    s_sub_u32 s40, s40, s47
    buffer_load_dwordx3 v[196:198], v2, s[16:19], s40 offen nt
    v_pk_add_f32 v[8:9], v[8:9], v[26:27]
    v_pk_add_f32 v[12:13], v[12:13], v[28:29]
    v_pk_add_f32 v[16:17], v[16:17], v[30:31]
    v_max3_f32 v10, v10, v20, v26
    v_max3_f32 v11, v11, v21, v27
    v_max3_f32 v14, v14, v22, v28
    v_max3_f32 v15, v15, v23, v29
    v_max3_f32 v18, v18, v24, v30
    v_max3_f32 v19, v19, v25, v31
    s_waitcnt vmcnt(7)
    v_lshlrev_b32 v20, 16, v168
    v_and_b32 v21, s48, v168
    v_lshlrev_b32 v22, 16, v169
    v_and_b32 v23, s48, v169
    v_lshlrev_b32 v24, 16, v170
    v_and_b32 v25, s48, v170
    s_waitcnt vmcnt(8)
    v_readfirstlane_b32 s10, v34
    v_readfirstlane_b32 s11, v35
    v_readfirstlane_b32 s14, v36
    v_readfirstlane_b32 s15, v37
    v_and_b32 v36, 1, v1
    v_cmp_eq_u32 vcc, 1, v36
    v_and_b32 v37, 7, v1
    v_lshlrev_b32 v36, 4, v36
    v_cndmask_b32 v38, v34, v35, vcc
    v_add_u32 v203, v38, v37
    v_and_b32 v37, 2, v1
    v_cmp_eq_u32 vcc, 2, v37
    s_and_b32 s6, s10, 0xffff
    s_lshr_b32 s7, s10, 16
    v_cndmask_b32 v38, v34, v35, vcc
    v_bfe_u32 v207, v38, v36, 16
    s_and_b32 s8, s11, 0xffff
    s_lshr_b32 s9, s11, 16
    s_min_u32 s42, s10, s11
    s_and_b32 s43, s14, s15
    s_and_b32 s43, s43, 0xff
    s_cmp_eq_u32 s43, 0xff
    s_cselect_b32 s42, s42, 0
    s_cmp_eq_u32 s42, 0
    s_cbranch_scc1 L_nonce
L_nonceback:
    s_lshr_b32 s42, s14, 8
    s_lshr_b32 s43, s14, 24
    s_xor_b32 s43, s43, s42
    s_and_b32 s43, s43, 63
    s_sub_u32 s44, s16, s28
    s_addk_i32 s44, 2048
    s_bitcmp1_b32 s44, 12
    s_cselect_b32 s43, 0, s43
    s_bcnt1_i32_b32 s44, s43
    s_cmp_gt_u32 s44, 2
    s_mov_b32 s52, 170
    s_cselect_b32 s52, 136, s52
    s_and_b32 s44, s4, 3
    s_add_u32 s44, s44, 16
    s_lshr_b32 s44, s14, s44
    s_lshr_b32 s45, s4, 2
    s_xor_b32 s44, s44, s45
    s_bitcmp1_b32 s44, 0
    s_cselect_b32 s44, -1, 0
    s_xor_b32 s42, s42, s44
    s_xor_b32 s43, s43, s42
    s_andn2_b32 s45, s2, 4
    s_mul_i32 s45, s45, 196608
    s_add_u32 s45, s45, s41
    s_add_u32 s60, s45, 49152
    s_bitcmp1_b32 s52, 0
    s_cselect_b32 s46, s43, s42
    s_lshr_b32 s47, s60, 23
    s_lshr_b32 s46, s46, s47
    s_add_u32 s47, s60, s28
    s_lshr_b32 s47, s47, 21
    s_xor_b32 s46, s46, s47
    s_bitcmp1_b32 s46, 0
    s_cselect_b32 s46, 24576, 0
    s_add_u32 s60, s60, s46
    buffer_load_dwordx3 v[200:202], v2, s[16:19], s60 offen nt
    v_pk_add_f32 v[8:9], v[8:9], v[20:21]
    v_pk_add_f32 v[12:13], v[12:13], v[22:23]
    v_pk_add_f32 v[16:17], v[16:17], v[24:25]
    s_waitcnt vmcnt(7)
    v_lshlrev_b32 v26, 16, v172
    v_and_b32 v27, s48, v172
    v_lshlrev_b32 v28, 16, v173
    v_and_b32 v29, s48, v173
    v_lshlrev_b32 v30, 16, v174
    v_and_b32 v31, s48, v174
    s_add_u32 s61, s45, 835584
    s_bitcmp1_b32 s52, 1
    s_cselect_b32 s46, s43, s42
    s_lshr_b32 s47, s61, 23
    s_lshr_b32 s46, s46, s47
    s_add_u32 s47, s61, s28
    s_lshr_b32 s47, s47, 21
    s_xor_b32 s46, s46, s47
    s_bitcmp1_b32 s46, 0
    s_cselect_b32 s46, 24576, 0
    s_add_u32 s61, s61, s46
    buffer_load_dwordx3 v[204:206], v111, s[16:19], s61 offen nt
    v_pk_add_f32 v[8:9], v[8:9], v[26:27]
    v_pk_add_f32 v[12:13], v[12:13], v[28:29]
    v_pk_add_f32 v[16:17], v[16:17], v[30:31]
    v_max3_f32 v10, v10, v20, v26
    v_max3_f32 v11, v11, v21, v27
    v_max3_f32 v14, v14, v22, v28
    v_max3_f32 v15, v15, v23, v29
    v_max3_f32 v18, v18, v24, v30
    v_max3_f32 v19, v19, v25, v31
    s_waitcnt vmcnt(7)
    v_lshlrev_b32 v20, 16, v176
    v_and_b32 v21, s48, v176
    v_lshlrev_b32 v22, 16, v177
    v_and_b32 v23, s48, v177
    v_lshlrev_b32 v24, 16, v178
    v_and_b32 v25, s48, v178
    s_add_u32 s62, s45, 67584
    s_bitcmp1_b32 s52, 2
    s_cselect_b32 s46, s43, s42
    s_lshr_b32 s47, s62, 23
    s_lshr_b32 s46, s46, s47
    s_add_u32 s47, s62, s28
    s_lshr_b32 s47, s47, 21
    s_xor_b32 s46, s46, s47
    s_bitcmp1_b32 s46, 0
    s_cselect_b32 s46, 24576, 0
    s_add_u32 s62, s62, s46
    buffer_load_dwordx3 v[208:210], v2, s[16:19], s62 offen nt
    v_pk_add_f32 v[8:9], v[8:9], v[20:21]
    v_pk_add_f32 v[12:13], v[12:13], v[22:23]
    v_pk_add_f32 v[16:17], v[16:17], v[24:25]
    s_waitcnt vmcnt(7)
    v_lshlrev_b32 v26, 16, v180
    v_and_b32 v27, s48, v180
    v_lshlrev_b32 v28, 16, v181
    v_and_b32 v29, s48, v181
    v_lshlrev_b32 v30, 16, v182
    v_and_b32 v31, s48, v182
    s_add_u32 s63, s45, 854016
    s_bitcmp1_b32 s52, 3
    s_cselect_b32 s46, s43, s42
    s_lshr_b32 s47, s63, 23
    s_lshr_b32 s46, s46, s47
    s_add_u32 s47, s63, s28
    s_lshr_b32 s47, s47, 21
    s_xor_b32 s46, s46, s47
    s_bitcmp1_b32 s46, 0
    s_cselect_b32 s46, 24576, 0
    s_add_u32 s63, s63, s46
    buffer_load_dwordx3 v[212:214], v111, s[16:19], s63 offen nt
    v_pk_add_f32 v[8:9], v[8:9], v[26:27]
    v_pk_add_f32 v[12:13], v[12:13], v[28:29]
    v_pk_add_f32 v[16:17], v[16:17], v[30:31]
    v_max3_f32 v10, v10, v20, v26
    v_max3_f32 v11, v11, v21, v27
    v_max3_f32 v14, v14, v22, v28
    v_max3_f32 v15, v15, v23, v29
    v_max3_f32 v18, v18, v24, v30
    v_max3_f32 v19, v19, v25, v31
    s_waitcnt vmcnt(7)
    v_lshlrev_b32 v20, 16, v184
    v_and_b32 v21, s48, v184
    v_lshlrev_b32 v22, 16, v185
    v_and_b32 v23, s48, v185
    v_lshlrev_b32 v24, 16, v186
    v_and_b32 v25, s48, v186
    s_add_u32 s64, s45, 98304
    s_bitcmp1_b32 s52, 4
    s_cselect_b32 s46, s43, s42
    s_lshr_b32 s47, s64, 23
    s_lshr_b32 s46, s46, s47
    s_add_u32 s47, s64, s28
    s_lshr_b32 s47, s47, 21
    s_xor_b32 s46, s46, s47
    s_bitcmp1_b32 s46, 0
    s_cselect_b32 s46, 24576, 0
    s_add_u32 s64, s64, s46
    buffer_load_dwordx3 v[216:218], v2, s[16:19], s64 offen nt
    v_pk_add_f32 v[8:9], v[8:9], v[20:21]
    v_pk_add_f32 v[12:13], v[12:13], v[22:23]
    v_pk_add_f32 v[16:17], v[16:17], v[24:25]
    s_waitcnt vmcnt(7)
    v_lshlrev_b32 v26, 16, v188
    v_and_b32 v27, s48, v188
    v_lshlrev_b32 v28, 16, v189
    v_and_b32 v29, s48, v189
    v_lshlrev_b32 v30, 16, v190
    v_and_b32 v31, s48, v190
    s_add_u32 s65, s45, 884736
    s_bitcmp1_b32 s52, 5
    s_cselect_b32 s46, s43, s42
    s_lshr_b32 s47, s65, 23
    s_lshr_b32 s46, s46, s47
    s_add_u32 s47, s65, s28
    s_lshr_b32 s47, s47, 21
    s_xor_b32 s46, s46, s47
    s_bitcmp1_b32 s46, 0
    s_cselect_b32 s46, 24576, 0
    s_add_u32 s65, s65, s46
    buffer_load_dwordx3 v[220:222], v111, s[16:19], s65 offen nt
    v_pk_add_f32 v[8:9], v[8:9], v[26:27]
    v_pk_add_f32 v[12:13], v[12:13], v[28:29]
    v_pk_add_f32 v[16:17], v[16:17], v[30:31]
    v_max3_f32 v10, v10, v20, v26
    v_max3_f32 v11, v11, v21, v27
    v_max3_f32 v14, v14, v22, v28
    v_max3_f32 v15, v15, v23, v29
    v_max3_f32 v18, v18, v24, v30
    v_max3_f32 v19, v19, v25, v31
    s_waitcnt vmcnt(7)
    v_lshlrev_b32 v20, 16, v192
    v_and_b32 v21, s48, v192
    v_lshlrev_b32 v22, 16, v193
    v_and_b32 v23, s48, v193
    v_lshlrev_b32 v24, 16, v194
    v_and_b32 v25, s48, v194
    s_add_u32 s66, s45, 116736
    s_bitcmp1_b32 s52, 6
    s_cselect_b32 s46, s43, s42
    s_lshr_b32 s47, s66, 23
    s_lshr_b32 s46, s46, s47
    s_add_u32 s47, s66, s28
    s_lshr_b32 s47, s47, 21
    s_xor_b32 s46, s46, s47
    s_bitcmp1_b32 s46, 0
    s_cselect_b32 s46, 24576, 0
    s_add_u32 s66, s66, s46
    buffer_load_dwordx3 v[224:226], v2, s[16:19], s66 offen nt
    v_pk_add_f32 v[8:9], v[8:9], v[20:21]
    v_pk_add_f32 v[12:13], v[12:13], v[22:23]
    v_pk_add_f32 v[16:17], v[16:17], v[24:25]
    s_waitcnt vmcnt(7)
    v_lshlrev_b32 v26, 16, v196
    v_and_b32 v27, s48, v196
    v_lshlrev_b32 v28, 16, v197
    v_and_b32 v29, s48, v197
    v_lshlrev_b32 v30, 16, v198
    v_and_b32 v31, s48, v198
    s_add_u32 s67, s45, 903168
    s_bitcmp1_b32 s52, 7
    s_cselect_b32 s46, s43, s42
    s_lshr_b32 s47, s67, 23
    s_lshr_b32 s46, s46, s47
    s_add_u32 s47, s67, s28
    s_lshr_b32 s47, s47, 21
    s_xor_b32 s46, s46, s47
    s_bitcmp1_b32 s46, 0
    s_cselect_b32 s46, 24576, 0
    s_add_u32 s67, s67, s46
    buffer_load_dwordx3 v[228:230], v111, s[16:19], s67 offen nt
    v_pk_add_f32 v[8:9], v[8:9], v[26:27]
    v_pk_add_f32 v[12:13], v[12:13], v[28:29]
    v_pk_add_f32 v[16:17], v[16:17], v[30:31]
    v_max3_f32 v10, v10, v20, v26
    v_max3_f32 v11, v11, v21, v27
    v_max3_f32 v14, v14, v22, v28
    v_max3_f32 v15, v15, v23, v29
    v_max3_f32 v18, v18, v24, v30
    v_max3_f32 v19, v19, v25, v31
    s_bfe_u32 s42, s15, 0x80008
    s_bcnt1_i32_b32 s42, s42
    s_cmp_gt_u32 s42, 4
    s_cselect_b32 s42, -1, 0
    s_lshr_b32 s43, s14, 16
    s_xor_b32 s42, s42, s43
    v_lshrrev_b32 v36, 3, v1
    v_bfe_u32 v36, s42, v36, 1
    v_lshl_add_u32 v143, v36, 13, v143
    s_lshr_b32 s43, s42, s4
    s_and_b32 s43, s43, 1
    s_lshl_b32 s43, s43, 13
    v_add_u32 v147, s43, v147
    s_xor_b32 s43, s4, 1
    s_lshr_b32 s43, s42, s43
    s_and_b32 s43, s43, 1
    s_lshl_b32 s43, s43, 13
    s_mov_b64 exec, 0x3f000000
    v_add_u32 v135, s43, v135
    s_mov_b64 exec, -1
    s_waitcnt vmcnt(7)
    v_lshlrev_b32 v20, 16, v200
    v_and_b32 v21, s48, v200
    v_lshlrev_b32 v22, 16, v201
    v_and_b32 v23, s48, v201
    v_lshlrev_b32 v24, 16, v202
    v_and_b32 v25, s48, v202
    v_pk_add_f32 v[8:9], v[8:9], v[20:21]
    v_pk_add_f32 v[12:13], v[12:13], v[22:23]
    v_pk_add_f32 v[16:17], v[16:17], v[24:25]
    s_waitcnt vmcnt(6)
    v_lshlrev_b32 v26, 16, v204
    v_and_b32 v27, s48, v204
    v_lshlrev_b32 v28, 16, v205
    v_and_b32 v29, s48, v205
    v_lshlrev_b32 v30, 16, v206
    v_and_b32 v31, s48, v206
    v_pk_add_f32 v[8:9], v[8:9], v[26:27]
    v_pk_add_f32 v[12:13], v[12:13], v[28:29]
    v_pk_add_f32 v[16:17], v[16:17], v[30:31]
    v_max3_f32 v10, v10, v20, v26
    v_max3_f32 v11, v11, v21, v27
    v_max3_f32 v14, v14, v22, v28
    v_max3_f32 v15, v15, v23, v29
    v_max3_f32 v18, v18, v24, v30
    v_max3_f32 v19, v19, v25, v31
    s_getpc_b64 s[46:47]
L_pc:
    s_lshl_b32 s42, s3, 10
    s_add_u32 s42, s42, L_acc - L_pc
    v_lshl_add_u32 v6, v1, 6, s42
    v_min_u32 v6, L_last - L_pc, v6
    v_mov_b32 v7, s47
    v_add_co_u32 v6, vcc, s46, v6
    s_mov_b64 exec, 0xffff
    s_nop 0
    v_addc_co_u32 v7, vcc, 0, v7, vcc
    global_load_dword v211, v[6:7], off
    s_mov_b64 exec, -1
    s_waitcnt vmcnt(6)
    v_lshlrev_b32 v20, 16, v208
    v_and_b32 v21, s48, v208
    v_lshlrev_b32 v22, 16, v209
    v_and_b32 v23, s48, v209
    v_lshlrev_b32 v24, 16, v210
    v_and_b32 v25, s48, v210
    v_pk_add_f32 v[8:9], v[8:9], v[20:21]
    v_pk_add_f32 v[12:13], v[12:13], v[22:23]
    v_pk_add_f32 v[16:17], v[16:17], v[24:25]
    s_waitcnt vmcnt(5)
    v_lshlrev_b32 v26, 16, v212
    v_and_b32 v27, s48, v212
    v_lshlrev_b32 v28, 16, v213
    v_and_b32 v29, s48, v213
    v_lshlrev_b32 v30, 16, v214
    v_and_b32 v31, s48, v214
    v_pk_add_f32 v[8:9], v[8:9], v[26:27]
    v_pk_add_f32 v[12:13], v[12:13], v[28:29]
    v_pk_add_f32 v[16:17], v[16:17], v[30:31]
    v_max3_f32 v10, v10, v20, v26
    v_max3_f32 v11, v11, v21, v27
    v_max3_f32 v14, v14, v22, v28
    v_max3_f32 v15, v15, v23, v29
    v_max3_f32 v18, v18, v24, v30
    v_max3_f32 v19, v19, v25, v31
    buffer_load_dword v211, v135, s[36:39], 0 offen sc1
    buffer_load_dword v211, v139, s[20:23], 0 offen
    buffer_load_dword v211, v139, s[24:27], 0 offen
    s_waitcnt vmcnt(7)
    v_lshlrev_b32 v20, 16, v216
    v_and_b32 v21, s48, v216
    v_lshlrev_b32 v22, 16, v217
    v_and_b32 v23, s48, v217
    v_lshlrev_b32 v24, 16, v218
    v_and_b32 v25, s48, v218
    v_pk_add_f32 v[8:9], v[8:9], v[20:21]
    v_pk_add_f32 v[12:13], v[12:13], v[22:23]
    v_pk_add_f32 v[16:17], v[16:17], v[24:25]
    s_waitcnt vmcnt(6)
    v_lshlrev_b32 v26, 16, v220
    v_and_b32 v27, s48, v220
    v_lshlrev_b32 v28, 16, v221
    v_and_b32 v29, s48, v221
    v_lshlrev_b32 v30, 16, v222
    v_and_b32 v31, s48, v222
    v_pk_add_f32 v[8:9], v[8:9], v[26:27]
    v_pk_add_f32 v[12:13], v[12:13], v[28:29]
    v_pk_add_f32 v[16:17], v[16:17], v[30:31]
    v_max3_f32 v10, v10, v20, v26
    v_max3_f32 v11, v11, v21, v27
    v_max3_f32 v14, v14, v22, v28
    v_max3_f32 v15, v15, v23, v29
    v_max3_f32 v18, v18, v24, v30
    v_max3_f32 v19, v19, v25, v31
    s_waitcnt vmcnt(5)
    v_lshlrev_b32 v20, 16, v224
    v_and_b32 v21, s48, v224
    v_lshlrev_b32 v22, 16, v225
    v_and_b32 v23, s48, v225
    v_lshlrev_b32 v24, 16, v226
    v_and_b32 v25, s48, v226
    v_pk_add_f32 v[8:9], v[8:9], v[20:21]
    v_pk_add_f32 v[12:13], v[12:13], v[22:23]
    v_pk_add_f32 v[16:17], v[16:17], v[24:25]
    s_waitcnt vmcnt(4)
    v_lshlrev_b32 v26, 16, v228
    v_and_b32 v27, s48, v228
    v_lshlrev_b32 v28, 16, v229
    v_and_b32 v29, s48, v229
    v_lshlrev_b32 v30, 16, v230
    v_and_b32 v31, s48, v230
    v_pk_add_f32 v[8:9], v[8:9], v[26:27]
    v_pk_add_f32 v[12:13], v[12:13], v[28:29]
    v_pk_add_f32 v[16:17], v[16:17], v[30:31]
    v_max3_f32 v10, v10, v20, v26
    v_max3_f32 v11, v11, v21, v27
    v_max3_f32 v14, v14, v22, v28
    v_max3_f32 v15, v15, v23, v29
    v_max3_f32 v18, v18, v24, v30
    v_max3_f32 v19, v19, v25, v31
L_acc:
    ds_write_b128 v115, v[8:11] offset:0
    ds_write_b128 v115, v[12:15] offset:16
    ds_write_b128 v115, v[16:19] offset:32
    s_waitcnt lgkmcnt(0)
    s_barrier
    s_cmp_ge_u32 s3, 3
    s_cbranch_scc1 L_nopub
    ds_read_b128 v[8:11], v123 offset:0
    ds_read_b128 v[12:15], v123 offset:3072
    ds_read_b128 v[16:19], v123 offset:6144
    ds_read_b128 v[20:23], v123 offset:9216
    ds_read_b128 v[24:27], v123 offset:12288
    ds_read_b128 v[28:31], v123 offset:15360
    ds_read_b128 v[32:35], v123 offset:18432
    ds_read_b128 v[36:39], v123 offset:21504
    s_waitcnt lgkmcnt(6)
    v_max_f32 v10, v10, v14
    v_max_f32 v11, v11, v15
    v_pk_add_f32 v[8:9], v[8:9], v[12:13]
    s_waitcnt lgkmcnt(4)
    v_max3_f32 v10, v10, v18, v22
    v_max3_f32 v11, v11, v19, v23
    v_pk_add_f32 v[16:17], v[16:17], v[20:21]
    v_pk_add_f32 v[8:9], v[8:9], v[16:17]
    s_waitcnt lgkmcnt(2)
    v_max3_f32 v10, v10, v26, v30
    v_max3_f32 v11, v11, v27, v31
    v_pk_add_f32 v[24:25], v[24:25], v[28:29]
    v_pk_add_f32 v[8:9], v[8:9], v[24:25]
    s_waitcnt lgkmcnt(0)
    v_max3_f32 v10, v10, v34, v38
    v_max3_f32 v11, v11, v35, v39
    v_pk_add_f32 v[32:33], v[32:33], v[36:37]
    v_cvt_pk_bf16_f32 v10, v10, v11
    v_pk_add_f32 v[8:9], v[8:9], v[32:33]
    v_pk_ashrrev_i16 v12, 15, v10 op_sel_hi:[0,1]
    v_bitop3_b32 v10, v10, v12, s49 bitop3:0x78
    v_bitop3_b32 v11, v8, v9, v10 bitop3:0x96
    v_xor_b32 v11, v11, v203
    buffer_store_dwordx4 v[8:11], v127, s[36:39], 0 offen
    s_cmp_lt_u32 s5, 6
    s_cbranch_scc1 L_mlp
    s_branch L_join
L_nopub:
    s_cmp_lt_u32 s5, 6
    s_cbranch_scc1 L_mlp
    s_cmp_lg_u32 s3, 4
    s_cbranch_scc1 L_mlpback
    s_cmp_lt_u32 s5, 8
    s_cbranch_scc1 L_join
    s_mov_b32 s50, 1048575
L_poll1:
    buffer_load_dwordx4 v[44:47], v131, s[36:39], 0 offen sc1
    buffer_load_dwordx4 v[48:51], v131, s[36:39], 0 offen offset:1024 sc1
    buffer_load_dwordx4 v[52:55], v131, s[36:39], 0 offen offset:2048 sc1
    buffer_load_dwordx4 v[56:59], v131, s[36:39], 0 offen offset:3072 sc1
    s_waitcnt vmcnt(3)
    v_bitop3_b32 v38, v44, v45, v46 bitop3:0x96
    v_bitop3_b32 v38, v38, v47, v203 bitop3:0x96
    s_waitcnt vmcnt(2)
    v_bitop3_b32 v39, v48, v49, v50 bitop3:0x96
    v_bitop3_b32 v39, v39, v51, v203 bitop3:0x96
    s_waitcnt vmcnt(1)
    v_bitop3_b32 v40, v52, v53, v54 bitop3:0x96
    v_bitop3_b32 v40, v40, v55, v203 bitop3:0x96
    v_or3_b32 v38, v38, v39, v40
    s_waitcnt vmcnt(0)
    v_bitop3_b32 v41, v56, v57, v58 bitop3:0x96
    v_bitop3_b32 v41, v41, v59, v203 bitop3:0x96
    v_or_b32 v38, v38, v41
    v_cmp_ne_u32 vcc, 0, v38
    s_cbranch_vccz L_poll1done
    s_and_b32 s51, s50, 63
    s_cbranch_scc1 L_poll1nowb
    buffer_wbl2 sc1
    s_waitcnt vmcnt(0)
    buffer_inv sc1
L_poll1nowb:
    s_sub_u32 s50, s50, 1
    s_cbranch_scc0 L_poll1
L_poll1done:
    v_pk_add_f32 v[8:9], v[44:45], v[48:49]
    v_pk_add_f32 v[16:17], v[52:53], v[56:57]
    v_pk_max_i16 v10, v46, v50
    v_pk_max_i16 v18, v54, v58
    v_pk_add_f32 v[8:9], v[8:9], v[16:17]
    v_pk_max_i16 v10, v10, v18
    s_nop 0
    v_add_f32_dpp v8, v8, v8 row_ror:8 row_mask:0xf bank_mask:0xf
    v_add_f32_dpp v9, v9, v9 row_ror:8 row_mask:0xf bank_mask:0xf
    v_mov_b32_dpp v14, v10 row_ror:8 row_mask:0xf bank_mask:0xf
    v_mov_b32 v12, v8
    v_mov_b32 v13, v9
    v_pk_max_i16 v10, v10, v14
    v_permlane16_swap_b32 v8, v12
    v_mov_b32 v14, v10
    v_permlane16_swap_b32 v9, v13
    v_add_f32 v8, v8, v12
    v_permlane16_swap_b32 v10, v14
    v_add_f32 v9, v9, v13
    v_mov_b32 v12, v8
    v_pk_max_i16 v10, v10, v14
    v_mov_b32 v13, v9
    v_permlane32_swap_b32 v8, v12
    v_mov_b32 v14, v10
    v_permlane32_swap_b32 v9, v13
    v_add_f32 v8, v8, v12
    v_permlane32_swap_b32 v10, v14
    v_add_f32 v9, v9, v13
    v_pk_max_i16 v10, v10, v14
    v_bitop3_b32 v11, v8, v9, v10 bitop3:0x96
    v_xor_b32 v11, v11, v203
    buffer_store_dwordx4 v[8:11], v143, s[36:39], 0 offen sc1
L_mlpback:
    s_cmp_lg_u32 s3, 7
    s_cbranch_scc1 L_join
    s_mov_b32 exec_hi, 0xffff
    s_mov_b32 s50, 1048575
L_poll3:
    buffer_load_dwordx4 v[76:79], v151, s[36:39], 0 offen sc1
    buffer_load_dwordx4 v[80:83], v151, s[36:39], 0 offen offset:768 sc1
    s_waitcnt vmcnt(1)
    v_xor_b32 v76, s6, v76
    v_xor_b32 v77, s7, v77
    v_xor_b32 v78, s8, v78
    v_xor_b32 v79, s9, v79
    ds_write_b128 v175, v[76:79] offset:0
    v_or3_b32 v38, v76, v77, v78
    s_waitcnt vmcnt(0)
    v_xor_b32 v80, s6, v80
    v_xor_b32 v81, s7, v81
    v_xor_b32 v82, s8, v82
    v_xor_b32 v83, s9, v83
    ds_write_b128 v175, v[80:83] offset:768
    v_or3_b32 v38, v38, v79, v80
    v_or3_b32 v39, v81, v82, v83
    v_or_b32 v38, v38, v39
    v_cmp_ne_u16 vcc, 0, v38
    s_cbranch_vccz L_poll3done
    s_and_b32 s51, s50, 63
    s_cbranch_scc1 L_poll3nowb
    buffer_wbl2 sc1
    s_waitcnt vmcnt(0)
    buffer_inv sc1
L_poll3nowb:
    s_sub_u32 s50, s50, 1
    s_cbranch_scc0 L_poll3
L_poll3done:
    s_mov_b64 exec, -1
    s_waitcnt lgkmcnt(0)
L_join:
    s_barrier
    ds_read_b64 v[32:33], v179 offset:0
    ds_read_b64 v[34:35], v179 offset:8
    ds_read_b64 v[36:37], v179 offset:16
    s_mul_i32 s40, s2, 196608
    s_add_u32 s51, s40, 196608
    v_lshlrev_b32 v8, 16, v104
    v_and_b32 v9, s48, v104
    v_lshlrev_b32 v10, 16, v105
    v_and_b32 v11, s48, v105
    v_lshlrev_b32 v12, 16, v106
    v_and_b32 v13, s48, v106
    s_waitcnt lgkmcnt(0)
    v_pk_mul_f32 v[8:9], v[8:9], v[32:33]
    v_pk_mul_f32 v[10:11], v[10:11], v[34:35]
    v_pk_mul_f32 v[12:13], v[12:13], v[36:37]
    v_cvt_pk_bf16_f32 v104, v8, v9
    v_cvt_pk_bf16_f32 v105, v10, v11
    v_cvt_pk_bf16_f32 v106, v12, v13
    buffer_store_dwordx3 v[104:106], v2, s[28:31], s40 offen sc1
    v_lshlrev_b32 v14, 16, v108
    v_and_b32 v15, s48, v108
    v_lshlrev_b32 v16, 16, v109
    v_and_b32 v17, s48, v109
    v_lshlrev_b32 v18, 16, v110
    v_and_b32 v19, s48, v110
    v_pk_mul_f32 v[14:15], v[14:15], v[32:33]
    v_pk_mul_f32 v[16:17], v[16:17], v[34:35]
    v_pk_mul_f32 v[18:19], v[18:19], v[36:37]
    v_cvt_pk_bf16_f32 v108, v14, v15
    v_cvt_pk_bf16_f32 v109, v16, v17
    v_cvt_pk_bf16_f32 v110, v18, v19
    s_addk_i32 s40, 6144
    buffer_store_dwordx3 v[108:110], v2, s[28:31], s40 offen sc1
    v_lshlrev_b32 v20, 16, v112
    v_and_b32 v21, s48, v112
    v_lshlrev_b32 v22, 16, v113
    v_and_b32 v23, s48, v113
    v_lshlrev_b32 v24, 16, v114
    v_and_b32 v25, s48, v114
    v_pk_mul_f32 v[20:21], v[20:21], v[32:33]
    v_pk_mul_f32 v[22:23], v[22:23], v[34:35]
    v_pk_mul_f32 v[24:25], v[24:25], v[36:37]
    v_cvt_pk_bf16_f32 v112, v20, v21
    v_cvt_pk_bf16_f32 v113, v22, v23
    v_cvt_pk_bf16_f32 v114, v24, v25
    s_addk_i32 s40, 6144
    buffer_store_dwordx3 v[112:114], v2, s[28:31], s40 offen sc1
    v_lshlrev_b32 v26, 16, v200
    v_and_b32 v27, s48, v200
    v_lshlrev_b32 v28, 16, v201
    v_and_b32 v29, s48, v201
    v_lshlrev_b32 v30, 16, v202
    v_and_b32 v31, s48, v202
    v_pk_mul_f32 v[26:27], v[26:27], v[32:33]
    v_pk_mul_f32 v[28:29], v[28:29], v[34:35]
    v_pk_mul_f32 v[30:31], v[30:31], v[36:37]
    v_cvt_pk_bf16_f32 v200, v26, v27
    v_cvt_pk_bf16_f32 v201, v28, v29
    v_cvt_pk_bf16_f32 v202, v30, v31
    buffer_store_dwordx3 v[200:202], v2, s[28:31], s60 offen sc1
    v_lshlrev_b32 v8, 16, v116
    v_and_b32 v9, s48, v116
    v_lshlrev_b32 v10, 16, v117
    v_and_b32 v11, s48, v117
    v_lshlrev_b32 v12, 16, v118
    v_and_b32 v13, s48, v118
    v_pk_mul_f32 v[8:9], v[8:9], v[32:33]
    v_pk_mul_f32 v[10:11], v[10:11], v[34:35]
    v_pk_mul_f32 v[12:13], v[12:13], v[36:37]
    v_cvt_pk_bf16_f32 v116, v8, v9
    v_cvt_pk_bf16_f32 v117, v10, v11
    v_cvt_pk_bf16_f32 v118, v12, v13
    s_addk_i32 s40, 6144
    buffer_store_dwordx3 v[116:118], v2, s[28:31], s40 offen sc1
    v_lshlrev_b32 v14, 16, v120
    v_and_b32 v15, s48, v120
    v_lshlrev_b32 v16, 16, v121
    v_and_b32 v17, s48, v121
    v_lshlrev_b32 v18, 16, v122
    v_and_b32 v19, s48, v122
    v_pk_mul_f32 v[14:15], v[14:15], v[32:33]
    v_pk_mul_f32 v[16:17], v[16:17], v[34:35]
    v_pk_mul_f32 v[18:19], v[18:19], v[36:37]
    v_cvt_pk_bf16_f32 v120, v14, v15
    v_cvt_pk_bf16_f32 v121, v16, v17
    v_cvt_pk_bf16_f32 v122, v18, v19
    s_addk_i32 s40, 6144
    buffer_store_dwordx3 v[120:122], v2, s[28:31], s40 offen sc1
    v_lshlrev_b32 v20, 16, v124
    v_and_b32 v21, s48, v124
    v_lshlrev_b32 v22, 16, v125
    v_and_b32 v23, s48, v125
    v_lshlrev_b32 v24, 16, v126
    v_and_b32 v25, s48, v126
    v_pk_mul_f32 v[20:21], v[20:21], v[32:33]
    v_pk_mul_f32 v[22:23], v[22:23], v[34:35]
    v_pk_mul_f32 v[24:25], v[24:25], v[36:37]
    v_cvt_pk_bf16_f32 v124, v20, v21
    v_cvt_pk_bf16_f32 v125, v22, v23
    v_cvt_pk_bf16_f32 v126, v24, v25
    s_addk_i32 s40, 6144
    buffer_store_dwordx3 v[124:126], v2, s[28:31], s40 offen sc1
    v_lshlrev_b32 v26, 16, v204
    v_and_b32 v27, s48, v204
    v_lshlrev_b32 v28, 16, v205
    v_and_b32 v29, s48, v205
    v_lshlrev_b32 v30, 16, v206
    v_and_b32 v31, s48, v206
    v_pk_mul_f32 v[26:27], v[26:27], v[32:33]
    v_pk_mul_f32 v[28:29], v[28:29], v[34:35]
    v_pk_mul_f32 v[30:31], v[30:31], v[36:37]
    v_cvt_pk_bf16_f32 v204, v26, v27
    v_cvt_pk_bf16_f32 v205, v28, v29
    v_cvt_pk_bf16_f32 v206, v30, v31
    buffer_store_dwordx3 v[204:206], v111, s[28:31], s61 offen sc1
    s_cmp_eq_u32 s12, 0
    s_cbranch_scc1 L_noc2
    s_mov_b64 exec, 0xffff
    buffer_store_dword v40, v155, s[36:39], 0 offen sc1
    s_mov_b64 exec, -1
L_noc2:
    v_lshlrev_b32 v8, 16, v128
    v_and_b32 v9, s48, v128
    v_lshlrev_b32 v10, 16, v129
    v_and_b32 v11, s48, v129
    v_lshlrev_b32 v12, 16, v130
    v_and_b32 v13, s48, v130
    v_pk_mul_f32 v[8:9], v[8:9], v[32:33]
    v_pk_mul_f32 v[10:11], v[10:11], v[34:35]
    v_pk_mul_f32 v[12:13], v[12:13], v[36:37]
    v_cvt_pk_bf16_f32 v128, v8, v9
    v_cvt_pk_bf16_f32 v129, v10, v11
    v_cvt_pk_bf16_f32 v130, v12, v13
    s_addk_i32 s40, 6144
    buffer_store_dwordx3 v[128:130], v2, s[28:31], s40 offen sc1
    v_lshlrev_b32 v14, 16, v132
    v_and_b32 v15, s48, v132
    v_lshlrev_b32 v16, 16, v133
    v_and_b32 v17, s48, v133
    v_lshlrev_b32 v18, 16, v134
    v_and_b32 v19, s48, v134
    v_pk_mul_f32 v[14:15], v[14:15], v[32:33]
    v_pk_mul_f32 v[16:17], v[16:17], v[34:35]
    v_pk_mul_f32 v[18:19], v[18:19], v[36:37]
    v_cvt_pk_bf16_f32 v132, v14, v15
    v_cvt_pk_bf16_f32 v133, v16, v17
    v_cvt_pk_bf16_f32 v134, v18, v19
    s_addk_i32 s40, 6144
    buffer_store_dwordx3 v[132:134], v2, s[28:31], s40 offen sc1
    v_lshlrev_b32 v20, 16, v136
    v_and_b32 v21, s48, v136
    v_lshlrev_b32 v22, 16, v137
    v_and_b32 v23, s48, v137
    v_lshlrev_b32 v24, 16, v138
    v_and_b32 v25, s48, v138
    v_pk_mul_f32 v[20:21], v[20:21], v[32:33]
    v_pk_mul_f32 v[22:23], v[22:23], v[34:35]
    v_pk_mul_f32 v[24:25], v[24:25], v[36:37]
    v_cvt_pk_bf16_f32 v136, v20, v21
    v_cvt_pk_bf16_f32 v137, v22, v23
    v_cvt_pk_bf16_f32 v138, v24, v25
    s_addk_i32 s40, 12288
    s_add_u32 s40, s40, s41
    buffer_store_dwordx3 v[136:138], v2, s[28:31], s40 offen sc1
    v_lshlrev_b32 v26, 16, v208
    v_and_b32 v27, s48, v208
    v_lshlrev_b32 v28, 16, v209
    v_and_b32 v29, s48, v209
    v_lshlrev_b32 v30, 16, v210
    v_and_b32 v31, s48, v210
    v_pk_mul_f32 v[26:27], v[26:27], v[32:33]
    v_pk_mul_f32 v[28:29], v[28:29], v[34:35]
    v_pk_mul_f32 v[30:31], v[30:31], v[36:37]
    v_cvt_pk_bf16_f32 v208, v26, v27
    v_cvt_pk_bf16_f32 v209, v28, v29
    v_cvt_pk_bf16_f32 v210, v30, v31
    buffer_store_dwordx3 v[208:210], v2, s[28:31], s62 offen sc1
    v_lshlrev_b32 v8, 16, v140
    v_and_b32 v9, s48, v140
    v_lshlrev_b32 v10, 16, v141
    v_and_b32 v11, s48, v141
    v_lshlrev_b32 v12, 16, v142
    v_and_b32 v13, s48, v142
    v_pk_mul_f32 v[8:9], v[8:9], v[32:33]
    v_pk_mul_f32 v[10:11], v[10:11], v[34:35]
    v_pk_mul_f32 v[12:13], v[12:13], v[36:37]
    v_cvt_pk_bf16_f32 v140, v8, v9
    v_cvt_pk_bf16_f32 v141, v10, v11
    v_cvt_pk_bf16_f32 v142, v12, v13
    s_addk_i32 s40, 6144
    buffer_store_dwordx3 v[140:142], v2, s[28:31], s40 offen sc1
    v_lshlrev_b32 v14, 16, v144
    v_and_b32 v15, s48, v144
    v_lshlrev_b32 v16, 16, v145
    v_and_b32 v17, s48, v145
    v_lshlrev_b32 v18, 16, v146
    v_and_b32 v19, s48, v146
    v_pk_mul_f32 v[14:15], v[14:15], v[32:33]
    v_pk_mul_f32 v[16:17], v[16:17], v[34:35]
    v_pk_mul_f32 v[18:19], v[18:19], v[36:37]
    v_cvt_pk_bf16_f32 v144, v14, v15
    v_cvt_pk_bf16_f32 v145, v16, v17
    v_cvt_pk_bf16_f32 v146, v18, v19
    s_addk_i32 s40, 18432
    buffer_store_dwordx3 v[144:146], v2, s[28:31], s40 offen sc1
    v_lshlrev_b32 v20, 16, v148
    v_and_b32 v21, s48, v148
    v_lshlrev_b32 v22, 16, v149
    v_and_b32 v23, s48, v149
    v_lshlrev_b32 v24, 16, v150
    v_and_b32 v25, s48, v150
    v_pk_mul_f32 v[20:21], v[20:21], v[32:33]
    v_pk_mul_f32 v[22:23], v[22:23], v[34:35]
    v_pk_mul_f32 v[24:25], v[24:25], v[36:37]
    v_cvt_pk_bf16_f32 v148, v20, v21
    v_cvt_pk_bf16_f32 v149, v22, v23
    v_cvt_pk_bf16_f32 v150, v24, v25
    s_addk_i32 s40, 6144
    buffer_store_dwordx3 v[148:150], v2, s[28:31], s40 offen sc1
    v_lshlrev_b32 v26, 16, v212
    v_and_b32 v27, s48, v212
    v_lshlrev_b32 v28, 16, v213
    v_and_b32 v29, s48, v213
    v_lshlrev_b32 v30, 16, v214
    v_and_b32 v31, s48, v214
    v_pk_mul_f32 v[26:27], v[26:27], v[32:33]
    v_pk_mul_f32 v[28:29], v[28:29], v[34:35]
    v_pk_mul_f32 v[30:31], v[30:31], v[36:37]
    v_cvt_pk_bf16_f32 v212, v26, v27
    v_cvt_pk_bf16_f32 v213, v28, v29
    v_cvt_pk_bf16_f32 v214, v30, v31
    buffer_store_dwordx3 v[212:214], v111, s[28:31], s63 offen sc1
    v_lshlrev_b32 v8, 16, v152
    v_and_b32 v9, s48, v152
    v_lshlrev_b32 v10, 16, v153
    v_and_b32 v11, s48, v153
    v_lshlrev_b32 v12, 16, v154
    v_and_b32 v13, s48, v154
    v_pk_mul_f32 v[8:9], v[8:9], v[32:33]
    v_pk_mul_f32 v[10:11], v[10:11], v[34:35]
    v_pk_mul_f32 v[12:13], v[12:13], v[36:37]
    v_cvt_pk_bf16_f32 v152, v8, v9
    v_cvt_pk_bf16_f32 v153, v10, v11
    v_cvt_pk_bf16_f32 v154, v12, v13
    s_addk_i32 s40, 18432
    buffer_store_dwordx3 v[152:154], v2, s[28:31], s40 offen sc1
    v_lshlrev_b32 v14, 16, v156
    v_and_b32 v15, s48, v156
    v_lshlrev_b32 v16, 16, v157
    v_and_b32 v17, s48, v157
    v_lshlrev_b32 v18, 16, v158
    v_and_b32 v19, s48, v158
    v_pk_mul_f32 v[14:15], v[14:15], v[32:33]
    v_pk_mul_f32 v[16:17], v[16:17], v[34:35]
    v_pk_mul_f32 v[18:19], v[18:19], v[36:37]
    v_cvt_pk_bf16_f32 v156, v14, v15
    v_cvt_pk_bf16_f32 v157, v16, v17
    v_cvt_pk_bf16_f32 v158, v18, v19
    s_addk_i32 s40, 6144
    buffer_store_dwordx3 v[156:158], v2, s[28:31], s40 offen sc1
    v_lshlrev_b32 v20, 16, v160
    v_and_b32 v21, s48, v160
    v_lshlrev_b32 v22, 16, v161
    v_and_b32 v23, s48, v161
    v_lshlrev_b32 v24, 16, v162
    v_and_b32 v25, s48, v162
    v_pk_mul_f32 v[20:21], v[20:21], v[32:33]
    v_pk_mul_f32 v[22:23], v[22:23], v[34:35]
    v_pk_mul_f32 v[24:25], v[24:25], v[36:37]
    v_cvt_pk_bf16_f32 v160, v20, v21
    v_cvt_pk_bf16_f32 v161, v22, v23
    v_cvt_pk_bf16_f32 v162, v24, v25
    s_addk_i32 s40, 18432
    buffer_store_dwordx3 v[160:162], v2, s[28:31], s40 offen sc1
    v_lshlrev_b32 v26, 16, v216
    v_and_b32 v27, s48, v216
    v_lshlrev_b32 v28, 16, v217
    v_and_b32 v29, s48, v217
    v_lshlrev_b32 v30, 16, v218
    v_and_b32 v31, s48, v218
    v_pk_mul_f32 v[26:27], v[26:27], v[32:33]
    v_pk_mul_f32 v[28:29], v[28:29], v[34:35]
    v_pk_mul_f32 v[30:31], v[30:31], v[36:37]
    v_cvt_pk_bf16_f32 v216, v26, v27
    v_cvt_pk_bf16_f32 v217, v28, v29
    v_cvt_pk_bf16_f32 v218, v30, v31
    buffer_store_dwordx3 v[216:218], v2, s[28:31], s64 offen sc1
    v_lshlrev_b32 v8, 16, v164
    v_and_b32 v9, s48, v164
    v_lshlrev_b32 v10, 16, v165
    v_and_b32 v11, s48, v165
    v_lshlrev_b32 v12, 16, v166
    v_and_b32 v13, s48, v166
    v_pk_mul_f32 v[8:9], v[8:9], v[32:33]
    v_pk_mul_f32 v[10:11], v[10:11], v[34:35]
    v_pk_mul_f32 v[12:13], v[12:13], v[36:37]
    v_cvt_pk_bf16_f32 v164, v8, v9
    v_cvt_pk_bf16_f32 v165, v10, v11
    v_cvt_pk_bf16_f32 v166, v12, v13
    s_addk_i32 s40, 6144
    buffer_store_dwordx3 v[164:166], v2, s[28:31], s40 offen sc1
    v_lshlrev_b32 v14, 16, v168
    v_and_b32 v15, s48, v168
    v_lshlrev_b32 v16, 16, v169
    v_and_b32 v17, s48, v169
    v_lshlrev_b32 v18, 16, v170
    v_and_b32 v19, s48, v170
    v_pk_mul_f32 v[14:15], v[14:15], v[32:33]
    v_pk_mul_f32 v[16:17], v[16:17], v[34:35]
    v_pk_mul_f32 v[18:19], v[18:19], v[36:37]
    v_cvt_pk_bf16_f32 v168, v14, v15
    v_cvt_pk_bf16_f32 v169, v16, v17
    v_cvt_pk_bf16_f32 v170, v18, v19
    s_addk_i32 s40, 12288
    buffer_store_dwordx3 v[168:170], v2, s[28:31], s40 offen sc1
    v_lshlrev_b32 v20, 16, v172
    v_and_b32 v21, s48, v172
    v_lshlrev_b32 v22, 16, v173
    v_and_b32 v23, s48, v173
    v_lshlrev_b32 v24, 16, v174
    v_and_b32 v25, s48, v174
    v_pk_mul_f32 v[20:21], v[20:21], v[32:33]
    v_pk_mul_f32 v[22:23], v[22:23], v[34:35]
    v_pk_mul_f32 v[24:25], v[24:25], v[36:37]
    v_cvt_pk_bf16_f32 v172, v20, v21
    v_cvt_pk_bf16_f32 v173, v22, v23
    v_cvt_pk_bf16_f32 v174, v24, v25
    s_addk_i32 s40, 6144
    s_cmp_ge_u32 s40, s51
    s_cselect_b32 s47, 147456, 0
    s_sub_u32 s40, s40, s47
    buffer_store_dwordx3 v[172:174], v2, s[28:31], s40 offen sc1
    v_lshlrev_b32 v26, 16, v220
    v_and_b32 v27, s48, v220
    v_lshlrev_b32 v28, 16, v221
    v_and_b32 v29, s48, v221
    v_lshlrev_b32 v30, 16, v222
    v_and_b32 v31, s48, v222
    v_pk_mul_f32 v[26:27], v[26:27], v[32:33]
    v_pk_mul_f32 v[28:29], v[28:29], v[34:35]
    v_pk_mul_f32 v[30:31], v[30:31], v[36:37]
    v_cvt_pk_bf16_f32 v220, v26, v27
    v_cvt_pk_bf16_f32 v221, v28, v29
    v_cvt_pk_bf16_f32 v222, v30, v31
    buffer_store_dwordx3 v[220:222], v111, s[28:31], s65 offen sc1
    v_lshlrev_b32 v8, 16, v176
    v_and_b32 v9, s48, v176
    v_lshlrev_b32 v10, 16, v177
    v_and_b32 v11, s48, v177
    v_lshlrev_b32 v12, 16, v178
    v_and_b32 v13, s48, v178
    v_pk_mul_f32 v[8:9], v[8:9], v[32:33]
    v_pk_mul_f32 v[10:11], v[10:11], v[34:35]
    v_pk_mul_f32 v[12:13], v[12:13], v[36:37]
    v_cvt_pk_bf16_f32 v176, v8, v9
    v_cvt_pk_bf16_f32 v177, v10, v11
    v_cvt_pk_bf16_f32 v178, v12, v13
    s_addk_i32 s40, 6144
    s_cmp_ge_u32 s40, s51
    s_cselect_b32 s47, 147456, 0
    s_sub_u32 s40, s40, s47
    buffer_store_dwordx3 v[176:178], v2, s[28:31], s40 offen sc1
    v_lshlrev_b32 v14, 16, v180
    v_and_b32 v15, s48, v180
    v_lshlrev_b32 v16, 16, v181
    v_and_b32 v17, s48, v181
    v_lshlrev_b32 v18, 16, v182
    v_and_b32 v19, s48, v182
    v_pk_mul_f32 v[14:15], v[14:15], v[32:33]
    v_pk_mul_f32 v[16:17], v[16:17], v[34:35]
    v_pk_mul_f32 v[18:19], v[18:19], v[36:37]
    v_cvt_pk_bf16_f32 v180, v14, v15
    v_cvt_pk_bf16_f32 v181, v16, v17
    v_cvt_pk_bf16_f32 v182, v18, v19
    s_addk_i32 s40, 6144
    s_cmp_ge_u32 s40, s51
    s_cselect_b32 s47, 147456, 0
    s_sub_u32 s40, s40, s47
    buffer_store_dwordx3 v[180:182], v2, s[28:31], s40 offen sc1
    v_lshlrev_b32 v20, 16, v184
    v_and_b32 v21, s48, v184
    v_lshlrev_b32 v22, 16, v185
    v_and_b32 v23, s48, v185
    v_lshlrev_b32 v24, 16, v186
    v_and_b32 v25, s48, v186
    v_pk_mul_f32 v[20:21], v[20:21], v[32:33]
    v_pk_mul_f32 v[22:23], v[22:23], v[34:35]
    v_pk_mul_f32 v[24:25], v[24:25], v[36:37]
    v_cvt_pk_bf16_f32 v184, v20, v21
    v_cvt_pk_bf16_f32 v185, v22, v23
    v_cvt_pk_bf16_f32 v186, v24, v25
    s_addk_i32 s40, 6144
    s_cmp_ge_u32 s40, s51
    s_cselect_b32 s47, 147456, 0
    s_sub_u32 s40, s40, s47
    buffer_store_dwordx3 v[184:186], v2, s[28:31], s40 offen sc1
    v_lshlrev_b32 v26, 16, v224
    v_and_b32 v27, s48, v224
    v_lshlrev_b32 v28, 16, v225
    v_and_b32 v29, s48, v225
    v_lshlrev_b32 v30, 16, v226
    v_and_b32 v31, s48, v226
    v_pk_mul_f32 v[26:27], v[26:27], v[32:33]
    v_pk_mul_f32 v[28:29], v[28:29], v[34:35]
    v_pk_mul_f32 v[30:31], v[30:31], v[36:37]
    v_cvt_pk_bf16_f32 v224, v26, v27
    v_cvt_pk_bf16_f32 v225, v28, v29
    v_cvt_pk_bf16_f32 v226, v30, v31
    buffer_store_dwordx3 v[224:226], v2, s[28:31], s66 offen sc1
    v_lshlrev_b32 v8, 16, v188
    v_and_b32 v9, s48, v188
    v_lshlrev_b32 v10, 16, v189
    v_and_b32 v11, s48, v189
    v_lshlrev_b32 v12, 16, v190
    v_and_b32 v13, s48, v190
    v_pk_mul_f32 v[8:9], v[8:9], v[32:33]
    v_pk_mul_f32 v[10:11], v[10:11], v[34:35]
    v_pk_mul_f32 v[12:13], v[12:13], v[36:37]
    v_cvt_pk_bf16_f32 v188, v8, v9
    v_cvt_pk_bf16_f32 v189, v10, v11
    v_cvt_pk_bf16_f32 v190, v12, v13
    s_addk_i32 s40, 6144
    s_cmp_ge_u32 s40, s51
    s_cselect_b32 s47, 147456, 0
    s_sub_u32 s40, s40, s47
    buffer_store_dwordx3 v[188:190], v2, s[28:31], s40 offen sc1
    v_lshlrev_b32 v14, 16, v192
    v_and_b32 v15, s48, v192
    v_lshlrev_b32 v16, 16, v193
    v_and_b32 v17, s48, v193
    v_lshlrev_b32 v18, 16, v194
    v_and_b32 v19, s48, v194
    v_pk_mul_f32 v[14:15], v[14:15], v[32:33]
    v_pk_mul_f32 v[16:17], v[16:17], v[34:35]
    v_pk_mul_f32 v[18:19], v[18:19], v[36:37]
    v_cvt_pk_bf16_f32 v192, v14, v15
    v_cvt_pk_bf16_f32 v193, v16, v17
    v_cvt_pk_bf16_f32 v194, v18, v19
    s_addk_i32 s40, 6144
    s_cmp_ge_u32 s40, s51
    s_cselect_b32 s47, 147456, 0
    s_sub_u32 s40, s40, s47
    buffer_store_dwordx3 v[192:194], v2, s[28:31], s40 offen sc1
    v_lshlrev_b32 v20, 16, v196
    v_and_b32 v21, s48, v196
    v_lshlrev_b32 v22, 16, v197
    v_and_b32 v23, s48, v197
    v_lshlrev_b32 v24, 16, v198
    v_and_b32 v25, s48, v198
    v_pk_mul_f32 v[20:21], v[20:21], v[32:33]
    v_pk_mul_f32 v[22:23], v[22:23], v[34:35]
    v_pk_mul_f32 v[24:25], v[24:25], v[36:37]
    v_cvt_pk_bf16_f32 v196, v20, v21
    v_cvt_pk_bf16_f32 v197, v22, v23
    v_cvt_pk_bf16_f32 v198, v24, v25
    s_addk_i32 s40, 6144
    s_cmp_ge_u32 s40, s51
    s_cselect_b32 s47, 147456, 0
    s_sub_u32 s40, s40, s47
    buffer_store_dwordx3 v[196:198], v2, s[28:31], s40 offen sc1
    v_lshlrev_b32 v26, 16, v228
    v_and_b32 v27, s48, v228
    v_lshlrev_b32 v28, 16, v229
    v_and_b32 v29, s48, v229
    v_lshlrev_b32 v30, 16, v230
    v_and_b32 v31, s48, v230
    v_pk_mul_f32 v[26:27], v[26:27], v[32:33]
    v_pk_mul_f32 v[28:29], v[28:29], v[34:35]
    v_pk_mul_f32 v[30:31], v[30:31], v[36:37]
    v_cvt_pk_bf16_f32 v228, v26, v27
    v_cvt_pk_bf16_f32 v229, v28, v29
    v_cvt_pk_bf16_f32 v230, v30, v31
    buffer_store_dwordx3 v[228:230], v111, s[28:31], s67 offen sc1
L_stdone:
L_end:
    s_endpgm
L_nonce:
    s_mov_b32 s50, 1048576
L_nonceloop:
    buffer_load_dwordx4 v[34:37], v107, s[32:35], 0 offen sc1
    s_waitcnt vmcnt(0)
    v_readfirstlane_b32 s10, v34
    v_readfirstlane_b32 s11, v35
    v_readfirstlane_b32 s14, v36
    v_readfirstlane_b32 s15, v37
    v_and_b32 v36, 1, v1
    v_cmp_eq_u32 vcc, 1, v36
    v_and_b32 v37, 7, v1
    v_lshlrev_b32 v36, 4, v36
    v_cndmask_b32 v38, v34, v35, vcc
    v_add_u32 v203, v38, v37
    v_and_b32 v37, 2, v1
    v_cmp_eq_u32 vcc, 2, v37
    s_and_b32 s6, s10, 0xffff
    s_lshr_b32 s7, s10, 16
    v_cndmask_b32 v38, v34, v35, vcc
    v_bfe_u32 v207, v38, v36, 16
    s_and_b32 s8, s11, 0xffff
    s_lshr_b32 s9, s11, 16
    s_min_u32 s42, s10, s11
    s_and_b32 s43, s14, s15
    s_and_b32 s43, s43, 0xff
    s_cmp_eq_u32 s43, 0xff
    s_cselect_b32 s42, s42, 0
    s_cmp_lg_u32 s42, 0
    s_cbranch_scc1 L_nonceback
    s_sleep 4
    s_sub_u32 s50, s50, 1
    s_cbranch_scc0 L_nonceloop
    s_branch L_nonceback
L_mlp:
    s_barrier
    s_mul_i32 s44, s3, 768
    s_mov_b32 m0, s44
    s_mov_b32 exec_hi, 0xffff
    buffer_load_dwordx4 v183, s[20:23], s44 offen lds
    s_mov_b32 exec_hi, -1
    s_addk_i32 s44, 6144
    s_mov_b32 m0, s44
    s_mov_b32 exec_hi, 0xffff
    buffer_load_dwordx4 v183, s[20:23], s44 offen lds
    s_mov_b32 exec_hi, -1
    s_addk_i32 s44, 6144
    s_mov_b32 m0, s44
    s_mov_b32 exec_hi, 0xffff
    buffer_load_dwordx4 v183, s[20:23], s44 offen lds
    s_mov_b32 exec_hi, -1
    s_addk_i32 s44, 6144
    s_mov_b32 m0, s44
    s_mov_b32 exec_hi, 0xffff
    buffer_load_dwordx4 v183, s[20:23], s44 offen lds
    s_mov_b32 exec_hi, -1
    s_addk_i32 s44, 6144
    s_mov_b32 m0, s44
    s_mov_b32 exec_hi, 0xffff
    buffer_load_dwordx4 v183, s[20:23], s44 offen lds
    s_mov_b32 exec_hi, -1
    s_addk_i32 s44, 6144
    s_mov_b32 m0, s44
    s_mov_b32 exec_hi, 0xffff
    buffer_load_dwordx4 v183, s[20:23], s44 offen lds
    s_mov_b32 exec_hi, -1
    s_addk_i32 s44, 6144
    s_mov_b32 m0, s44
    s_mov_b32 exec_hi, 0xffff
    buffer_load_dwordx4 v183, s[20:23], s44 offen lds
    s_mov_b32 exec_hi, -1
    s_addk_i32 s44, 6144
    s_mov_b32 m0, s44
    s_mov_b32 exec_hi, 0xffff
    buffer_load_dwordx4 v183, s[20:23], s44 offen lds
    s_mov_b32 exec_hi, -1
    s_addk_i32 s44, 6144
    s_mov_b32 m0, s44
    s_mov_b32 exec_hi, 0xffff
    buffer_load_dwordx4 v183, s[20:23], s44 offen lds
    s_mov_b32 exec_hi, -1
    s_addk_i32 s44, 6144
    s_mov_b32 m0, s44
    s_mov_b32 exec_hi, 0xffff
    buffer_load_dwordx4 v183, s[20:23], s44 offen lds
    s_mov_b32 exec_hi, -1
    s_addk_i32 s44, 6144
    s_mov_b32 m0, s44
    s_mov_b32 exec_hi, 0xffff
    buffer_load_dwordx4 v183, s[20:23], s44 offen lds
    s_mov_b32 exec_hi, -1
    s_addk_i32 s44, 6144
    s_mov_b32 m0, s44
    s_mov_b32 exec_hi, 0xffff
    buffer_load_dwordx4 v183, s[20:23], s44 offen lds
    s_mov_b32 exec_hi, -1
    s_lshl_b32 s45, s3, 10
    s_add_u32 m0, s45, 73728
    s_mul_i32 s44, s3, 6144
    buffer_load_dwordx4 v187, s[24:27], s44 offen lds
    s_add_u32 m0, m0, 8192
    s_add_u32 s44, s44, 49152
    buffer_load_dwordx4 v187, s[24:27], s44 offen lds
    s_movk_i32 s42, 16384
    s_mov_b32 s43, 32768
    s_mov_b32 s45, 49152
    s_waitcnt vmcnt(0)
    s_barrier
    s_cmp_ge_u32 s3, 6
    s_cbranch_scc1 L_nog
    ds_read_b64_tr_b16 v[44:45], v191 offset:0
    ds_read_b64_tr_b16 v[46:47], v191 offset:1536
    ds_read_b64_tr_b16 v[48:49], v191 offset:6144
    ds_read_b64_tr_b16 v[50:51], v191 offset:7680
    ds_read_b64_tr_b16 v[52:53], v191 offset:12288
    ds_read_b64_tr_b16 v[54:55], v191 offset:13824
    ds_read_b64_tr_b16 v[56:57], v191 offset:18432
    ds_read_b64_tr_b16 v[58:59], v191 offset:19968
    ds_read_b64_tr_b16 v[60:61], v191 offset:24576
    ds_read_b64_tr_b16 v[62:63], v191 offset:26112
    ds_read_b64_tr_b16 v[64:65], v191 offset:30720
    ds_read_b64_tr_b16 v[66:67], v191 offset:32256
    ds_read_b64_tr_b16 v[68:69], v195 offset:0
    ds_read_b64_tr_b16 v[70:71], v195 offset:1536
    ds_read_b64_tr_b16 v[72:73], v195 offset:6144
    ds_read_b64_tr_b16 v[74:75], v195 offset:7680
    ds_read_b64_tr_b16 v[76:77], v195 offset:12288
    ds_read_b64_tr_b16 v[78:79], v195 offset:13824
    ds_read_b64_tr_b16 v[80:81], v195 offset:18432
    ds_read_b64_tr_b16 v[82:83], v195 offset:19968
    ds_read_b64_tr_b16 v[84:85], v195 offset:24576
    ds_read_b64_tr_b16 v[86:87], v195 offset:26112
    ds_read_b64_tr_b16 v[88:89], v195 offset:30720
    ds_read_b64_tr_b16 v[90:91], v195 offset:32256
    ds_read_b64_tr_b16 v[92:93], v199 offset:0
    ds_read_b64_tr_b16 v[94:95], v199 offset:1024
    ds_read_b64_tr_b16 v[96:97], v199 offset:4096
    ds_read_b64_tr_b16 v[98:99], v199 offset:5120
    ds_read_b64_tr_b16 v[100:101], v199 offset:8192
    ds_read_b64_tr_b16 v[102:103], v199 offset:9216
    s_mov_b32 s50, 1048575
L_poll2:
    buffer_load_dwordx4 v[20:23], v147, s[36:39], 0 offen sc1
    buffer_load_dwordx4 v[24:27], v147, s[36:39], s42 offen sc1
    buffer_load_dwordx4 v[28:31], v147, s[36:39], s43 offen sc1
    buffer_load_dwordx4 v[32:35], v147, s[36:39], s45 offen sc1
    s_waitcnt vmcnt(3)
    v_bitop3_b32 v38, v20, v21, v22 bitop3:0x96
    v_bitop3_b32 v38, v38, v23, v203 bitop3:0x96
    s_waitcnt vmcnt(2)
    v_bitop3_b32 v39, v24, v25, v26 bitop3:0x96
    v_bitop3_b32 v39, v39, v27, v203 bitop3:0x96
    s_waitcnt vmcnt(1)
    v_bitop3_b32 v40, v28, v29, v30 bitop3:0x96
    v_bitop3_b32 v40, v40, v31, v203 bitop3:0x96
    v_or3_b32 v38, v38, v39, v40
    s_waitcnt vmcnt(0)
    v_bitop3_b32 v41, v32, v33, v34 bitop3:0x96
    v_bitop3_b32 v41, v41, v35, v203 bitop3:0x96
    v_or_b32 v38, v38, v41
    v_cmp_ne_u32 vcc, 0, v38
    s_cbranch_vccz L_poll2done
    s_and_b32 s51, s50, 63
    s_cbranch_scc1 L_poll2nowb
    buffer_wbl2 sc1
    s_waitcnt vmcnt(0)
    buffer_inv sc1
L_poll2nowb:
    s_sub_u32 s50, s50, 1
    s_cbranch_scc0 L_poll2
L_poll2done:
    v_pk_add_f32 v[8:9], v[20:21], v[24:25]
    v_pk_add_f32 v[16:17], v[28:29], v[32:33]
    v_pk_max_i16 v10, v22, v26
    v_pk_max_i16 v18, v30, v34
    v_pk_add_f32 v[8:9], v[8:9], v[16:17]
    v_pk_max_i16 v10, v10, v18
    v_mov_b32 v12, v8
    v_mov_b32 v13, v9
    v_mov_b32 v14, v10
    v_permlane32_swap_b32 v8, v12
    v_permlane32_swap_b32 v9, v13
    v_permlane32_swap_b32 v10, v14
    v_pk_add_f32 v[8:9], v[8:9], v[12:13]
    v_pk_max_i16 v10, v10, v14
    v_mul_f32 v8, 0x37800000, v8
    v_mul_f32 v9, 0x37800000, v9
    v_pk_ashrrev_i16 v12, 15, v10 op_sel_hi:[0,1]
    v_bitop3_b32 v10, v10, v12, s49 bitop3:0x78
    v_cvt_pk_bf16_f32 v8, v8, v9
    s_mov_b32 exec_hi, 0
    ds_write2_b32 v159, v8, v10 offset0:0 offset1:208
    s_mov_b32 exec_hi, -1
    s_waitcnt lgkmcnt(0)
L_nog:
    s_barrier
    s_cmp_ge_u32 s3, 6
    s_cbranch_scc1 L_nol1
    ds_read_b128 v[8:11], v163 offset:0
    ds_read_b128 v[12:15], v163 offset:64
    ds_read_b128 v[16:19], v163 offset:128
    ds_read_b128 v[20:23], v163 offset:192
    ds_read_b128 v[24:27], v163 offset:256
    ds_read_b128 v[28:31], v163 offset:320
    ds_read_b128 v[32:35], v163 offset:384
    ds_read_b128 v[36:39], v163 offset:448
    s_waitcnt lgkmcnt(7)
    v_mfma_f32_16x16x32_bf16 v[40:43], v[44:47], v[8:11], 0
    ds_read_b128 v[8:11], v163 offset:512
    s_waitcnt lgkmcnt(7)
    v_mfma_f32_16x16x32_bf16 v[40:43], v[48:51], v[12:15], v[40:43]
    ds_read_b128 v[12:15], v163 offset:576
    s_waitcnt lgkmcnt(7)
    v_mfma_f32_16x16x32_bf16 v[40:43], v[52:55], v[16:19], v[40:43]
    ds_read_b128 v[16:19], v163 offset:640
    s_waitcnt lgkmcnt(7)
    v_mfma_f32_16x16x32_bf16 v[40:43], v[56:59], v[20:23], v[40:43]
    ds_read_b128 v[20:23], v163 offset:704
    s_waitcnt lgkmcnt(7)
    v_mfma_f32_16x16x32_bf16 v[40:43], v[60:63], v[24:27], v[40:43]
    s_waitcnt lgkmcnt(6)
    v_mfma_f32_16x16x32_bf16 v[40:43], v[64:67], v[28:31], v[40:43]
    s_waitcnt lgkmcnt(5)
    v_mfma_f32_16x16x32_bf16 v[40:43], v[68:71], v[32:35], v[40:43]
    s_waitcnt lgkmcnt(4)
    v_mfma_f32_16x16x32_bf16 v[40:43], v[72:75], v[36:39], v[40:43]
    s_waitcnt lgkmcnt(3)
    v_mfma_f32_16x16x32_bf16 v[40:43], v[76:79], v[8:11], v[40:43]
    s_waitcnt lgkmcnt(2)
    v_mfma_f32_16x16x32_bf16 v[40:43], v[80:83], v[12:15], v[40:43]
    s_waitcnt lgkmcnt(1)
    v_mfma_f32_16x16x32_bf16 v[40:43], v[84:87], v[16:19], v[40:43]
    s_waitcnt lgkmcnt(0)
    v_mfma_f32_16x16x32_bf16 v[40:43], v[88:91], v[20:23], v[40:43]
    s_nop 7
    v_mul_f32 v8, 0, v40
    v_cmp_lt_f32 s[52:53], 0, v40
    v_mul_f32 v9, 0, v41
    v_cmp_lt_f32 s[54:55], 0, v41
    v_mul_f32 v10, 0, v42
    v_cmp_lt_f32 s[56:57], 0, v42
    v_mul_f32 v11, 0, v43
    v_cmp_lt_f32 s[58:59], 0, v43
    s_mov_b32 exec_lo, 0x00030003
    s_mov_b32 exec_hi, 0x00030003
    v_cndmask_b32 v8, v8, v40, s[52:53]
    v_cndmask_b32 v9, v9, v41, s[54:55]
    v_cndmask_b32 v10, v10, v42, s[56:57]
    v_cndmask_b32 v11, v11, v43, s[58:59]
    v_cvt_pk_bf16_f32 v12, v8, v9
    v_cvt_pk_bf16_f32 v13, v10, v11
    ds_write_b64 v171, v[12:13]
    s_mov_b64 exec, -1
    s_waitcnt lgkmcnt(0)
L_nol1:
    s_barrier
    s_cmp_ge_u32 s3, 4
    s_cbranch_scc1 L_mlpback
    ds_read_b128 v[8:11], v167 offset:0
    ds_read_b128 v[12:15], v167 offset:64
    ds_read_b128 v[16:19], v167 offset:128
    s_waitcnt lgkmcnt(2)
    v_mfma_f32_16x16x32_bf16 v[20:23], v[8:11], v[92:95], 0
    s_waitcnt lgkmcnt(1)
    v_mfma_f32_16x16x32_bf16 v[20:23], v[12:15], v[96:99], v[20:23]
    s_waitcnt lgkmcnt(0)
    v_mfma_f32_16x16x32_bf16 v[20:23], v[16:19], v[100:103], v[20:23]
    s_nop 7
    v_cvt_pk_bf16_f32 v8, v20, v21
    v_lshlrev_b32 v9, 16, v8
    v_and_b32 v8, s48, v8
    v_add_f32 v8, v8, v9
    v_cvt_pk_bf16_f32 v8, v8, v8
    v_and_b32 v8, s48, v8
    v_mul_f32 v8, 0xbfb8aa3b, v8
    v_exp_f32 v8, v8
    s_mov_b64 exec, 0xffff
    v_add_f32 v8, 1.0, v8
    v_rcp_f32 v8, v8
    s_nop 0
    v_cvt_pk_bf16_f32 v8, v8, v8
    v_and_or_b32 v40, v8, s48, v207
    buffer_store_dword v40, v155, s[36:39], 0 offen
    s_mov_b32 s12, 1
    s_mov_b64 exec, -1
L_last:
    s_branch L_join
.section .rodata,"a"
.p2align 6
.amdhsa_kernel standalone__channel_attn_cbam__vision_kernel
  .amdhsa_next_free_vgpr 256
  .amdhsa_next_free_sgpr 102
  .amdhsa_accum_offset 256
  .amdhsa_group_segment_fixed_size 0
  .amdhsa_kernarg_size 48
  .amdhsa_user_sgpr_count 2
  .amdhsa_user_sgpr_kernarg_segment_ptr 1
  .amdhsa_system_sgpr_workgroup_id_x 1
  .amdhsa_float_denorm_mode_32 3
.end_amdhsa_kernel
```
